```python
import torch

def _softmax(x, axis=-1):
    return torch.softmax(x, dim=axis)
def _gelu(x):
    return torch.nn.functional.gelu(x, approximate="tanh")
def _silu(x):
    return torch.nn.functional.silu(x)
def _sigmoid(x):
    return torch.sigmoid(x)
def _layernorm(x, axis=-1, eps=1e-5):
    m = x.mean(dim=axis, keepdim=True)
    v = x.var(dim=axis, keepdim=True, unbiased=False)
    return (x - m) / torch.sqrt(v + eps)
def _scatter_add(tgt, idx, src, axis=0):
    return tgt.clone().index_add_(axis, idx, src)
def _segment_sum(src, seg, n):
    out = torch.zeros((n,) + src.shape[1:], dtype=src.dtype)
    return out.index_add_(0, seg, src)
def _pad(x, pw):
    flat = tuple(v for pair in reversed(pw) for v in pair)
    return torch.nn.functional.pad(x, flat)

kernel_name = 'standalone__instancenorm__prompt'

def setup_inputs():

    _w = (lambda a: (lambda t: t.to(torch.bfloat16) if t.is_floating_point() else t)(torch.as_tensor(a)))
    B, C, H, W = 2, 448, 2048, 16
    return {
        "x": _w(abs((lambda *s: torch.randn(*s, dtype=torch.bfloat16) * 0.05)(B, C, H, W))),
        "g": _w((lambda *s: torch.randn(*s, dtype=torch.bfloat16) * 0.05)(C) + 1.0),
        "b": _w((lambda *s: torch.randn(*s, dtype=torch.bfloat16) * 0.4)(C)),
    }

def reference(x, g, b):
    mu = x.mean(axis=(-2, -1), keepdims=True)
    var = ((x - mu) ** 2).mean(axis=(-2, -1), keepdims=True)
    xhat = (x - mu) / torch.sqrt(var + 1e-5)
    return xhat * g.reshape(1, -1, 1, 1) + b.reshape(1, -1, 1, 1)
```

```asm
; @launch grid=(896,1,1) block=(256,1,1) lds=64
.amdgcn_target "amdgcn-amd-amdhsa--gfx950"
.text
.globl standalone__instancenorm__prompt_kernel
.p2align 8
.type standalone__instancenorm__prompt_kernel,@function
standalone__instancenorm__prompt_kernel:
    s_cmp_ge_u32 s2, 896
    s_cbranch_scc1 L_end
    s_load_dwordx4 s[4:7], s[0:1], 0
    s_load_dwordx4 s[8:11], s[0:1], 16
    v_lshrrev_b32 v12, 6, v0
    v_and_b32 v1, 63, v0
    v_lshlrev_b32 v1, 4, v1
    v_lshl_add_u32 v1, v12, 14, v1
    v_lshlrev_b32 v12, 3, v12
    v_mov_b32 v13, 0
    s_mov_b32 s30, 0x00003f80
    s_mov_b32 s31, 0x3f800000
    s_sub_u32 s24, s2, 448
    s_cmp_ge_u32 s2, 448
    s_cselect_b32 s24, s24, s2
    s_and_b32 s25, s24, 0xfffffffe
    s_lshl_b32 s25, s25, 1
    s_lshl_b32 s56, s2, 16
    s_add_u32 s57, s56, 4096
    s_add_u32 s58, s56, 8192
    s_add_u32 s59, s56, 12288
    s_waitcnt lgkmcnt(0)
    s_mov_b32 s12, s4
    s_mov_b32 s13, s5
    s_mov_b32 s14, 0x3800000
    s_mov_b32 s15, 0x00020000
    s_mov_b32 s16, s10
    s_mov_b32 s17, s11
    s_mov_b32 s18, 0x3800000
    s_mov_b32 s19, 0x00020000
    s_load_dword s26, s[6:7], s25
    s_load_dword s27, s[8:9], s25
    buffer_load_dwordx4 v[16:19], v1, s[12:15], s56 offen offset:0 nt
    buffer_load_dwordx4 v[20:23], v1, s[12:15], s56 offen offset:1024 nt
    buffer_load_dwordx4 v[24:27], v1, s[12:15], s56 offen offset:2048 nt
    buffer_load_dwordx4 v[28:31], v1, s[12:15], s56 offen offset:3072 nt
    buffer_load_dwordx4 v[32:35], v1, s[12:15], s57 offen offset:0 nt
    buffer_load_dwordx4 v[36:39], v1, s[12:15], s57 offen offset:1024 nt
    buffer_load_dwordx4 v[40:43], v1, s[12:15], s57 offen offset:2048 nt
    buffer_load_dwordx4 v[44:47], v1, s[12:15], s57 offen offset:3072 nt
    buffer_load_dwordx4 v[48:51], v1, s[12:15], s58 offen offset:0 nt
    buffer_load_dwordx4 v[52:55], v1, s[12:15], s58 offen offset:1024 nt
    buffer_load_dwordx4 v[56:59], v1, s[12:15], s58 offen offset:2048 nt
    buffer_load_dwordx4 v[60:63], v1, s[12:15], s58 offen offset:3072 nt
    buffer_load_dwordx4 v[64:67], v1, s[12:15], s59 offen offset:0 nt
    buffer_load_dwordx4 v[68:71], v1, s[12:15], s59 offen offset:1024 nt
    buffer_load_dwordx4 v[72:75], v1, s[12:15], s59 offen offset:2048 nt
    buffer_load_dwordx4 v[76:79], v1, s[12:15], s59 offen offset:3072 nt
    v_mov_b32 v3, 0
    v_mov_b32 v4, 0
    v_mov_b32 v5, 0
    v_mov_b32 v6, 0
    s_mov_b32 s29, 0x3c000000
    s_waitcnt vmcnt(15)
    v_lshlrev_b32 v7, 16, v16
    v_xor_b32 v2, 0x80000000, v7
    v_dot2_f32_bf16 v80, v16, s30, v2
    v_dot2_f32_bf16 v81, v16, s31, v2
    v_dot2_f32_bf16 v82, v17, s30, v2
    v_dot2_f32_bf16 v83, v17, s31, v2
    v_dot2_f32_bf16 v84, v18, s30, v2
    v_dot2_f32_bf16 v85, v18, s31, v2
    v_dot2_f32_bf16 v86, v19, s30, v2
    v_dot2_f32_bf16 v87, v19, s31, v2
    v_add_f32 v3, v3, v80
    v_fmac_f32 v5, v80, v80
    v_add_f32 v4, v4, v81
    v_fmac_f32 v6, v81, v81
    v_add_f32 v3, v3, v82
    v_fmac_f32 v5, v82, v82
    v_add_f32 v4, v4, v83
    v_fmac_f32 v6, v83, v83
    v_add_f32 v3, v3, v84
    v_fmac_f32 v5, v84, v84
    v_add_f32 v4, v4, v85
    v_fmac_f32 v6, v85, v85
    v_add_f32 v3, v3, v86
    v_fmac_f32 v5, v86, v86
    v_add_f32 v4, v4, v87
    v_fmac_f32 v6, v87, v87
    s_waitcnt vmcnt(14)
    v_dot2_f32_bf16 v80, v20, s30, v2
    v_dot2_f32_bf16 v81, v20, s31, v2
    v_dot2_f32_bf16 v82, v21, s30, v2
    v_dot2_f32_bf16 v83, v21, s31, v2
    v_dot2_f32_bf16 v84, v22, s30, v2
    v_dot2_f32_bf16 v85, v22, s31, v2
    v_dot2_f32_bf16 v86, v23, s30, v2
    v_dot2_f32_bf16 v87, v23, s31, v2
    v_add_f32 v3, v3, v80
    v_fmac_f32 v5, v80, v80
    v_add_f32 v4, v4, v81
    v_fmac_f32 v6, v81, v81
    v_add_f32 v3, v3, v82
    v_fmac_f32 v5, v82, v82
    v_add_f32 v4, v4, v83
    v_fmac_f32 v6, v83, v83
    v_add_f32 v3, v3, v84
    v_fmac_f32 v5, v84, v84
    v_add_f32 v4, v4, v85
    v_fmac_f32 v6, v85, v85
    v_add_f32 v3, v3, v86
    v_fmac_f32 v5, v86, v86
    v_add_f32 v4, v4, v87
    v_fmac_f32 v6, v87, v87
    s_waitcnt vmcnt(13)
    v_dot2_f32_bf16 v80, v24, s30, v2
    v_dot2_f32_bf16 v81, v24, s31, v2
    v_dot2_f32_bf16 v82, v25, s30, v2
    v_dot2_f32_bf16 v83, v25, s31, v2
    v_dot2_f32_bf16 v84, v26, s30, v2
    v_dot2_f32_bf16 v85, v26, s31, v2
    v_dot2_f32_bf16 v86, v27, s30, v2
    v_dot2_f32_bf16 v87, v27, s31, v2
    v_add_f32 v3, v3, v80
    v_fmac_f32 v5, v80, v80
    v_add_f32 v4, v4, v81
    v_fmac_f32 v6, v81, v81
    v_add_f32 v3, v3, v82
    v_fmac_f32 v5, v82, v82
    v_add_f32 v4, v4, v83
    v_fmac_f32 v6, v83, v83
    v_add_f32 v3, v3, v84
    v_fmac_f32 v5, v84, v84
    v_add_f32 v4, v4, v85
    v_fmac_f32 v6, v85, v85
    v_add_f32 v3, v3, v86
    v_fmac_f32 v5, v86, v86
    v_add_f32 v4, v4, v87
    v_fmac_f32 v6, v87, v87
    s_waitcnt vmcnt(12)
    v_dot2_f32_bf16 v80, v28, s30, v2
    v_dot2_f32_bf16 v81, v28, s31, v2
    v_dot2_f32_bf16 v82, v29, s30, v2
    v_dot2_f32_bf16 v83, v29, s31, v2
    v_dot2_f32_bf16 v84, v30, s30, v2
    v_dot2_f32_bf16 v85, v30, s31, v2
    v_dot2_f32_bf16 v86, v31, s30, v2
    v_dot2_f32_bf16 v87, v31, s31, v2
    v_add_f32 v3, v3, v80
    v_fmac_f32 v5, v80, v80
    v_add_f32 v4, v4, v81
    v_fmac_f32 v6, v81, v81
    v_add_f32 v3, v3, v82
    v_fmac_f32 v5, v82, v82
    v_add_f32 v4, v4, v83
    v_fmac_f32 v6, v83, v83
    v_add_f32 v3, v3, v84
    v_fmac_f32 v5, v84, v84
    v_add_f32 v4, v4, v85
    v_fmac_f32 v6, v85, v85
    v_add_f32 v3, v3, v86
    v_fmac_f32 v5, v86, v86
    v_add_f32 v4, v4, v87
    v_fmac_f32 v6, v87, v87
    s_waitcnt vmcnt(11)
    v_dot2_f32_bf16 v80, v32, s30, v2
    v_dot2_f32_bf16 v81, v32, s31, v2
    v_dot2_f32_bf16 v82, v33, s30, v2
    v_dot2_f32_bf16 v83, v33, s31, v2
    v_dot2_f32_bf16 v84, v34, s30, v2
    v_dot2_f32_bf16 v85, v34, s31, v2
    v_dot2_f32_bf16 v86, v35, s30, v2
    v_dot2_f32_bf16 v87, v35, s31, v2
    v_add_f32 v3, v3, v80
    v_fmac_f32 v5, v80, v80
    v_add_f32 v4, v4, v81
    v_fmac_f32 v6, v81, v81
    v_add_f32 v3, v3, v82
    v_fmac_f32 v5, v82, v82
    v_add_f32 v4, v4, v83
    v_fmac_f32 v6, v83, v83
    v_add_f32 v3, v3, v84
    v_fmac_f32 v5, v84, v84
    v_add_f32 v4, v4, v85
    v_fmac_f32 v6, v85, v85
    v_add_f32 v3, v3, v86
    v_fmac_f32 v5, v86, v86
    v_add_f32 v4, v4, v87
    v_fmac_f32 v6, v87, v87
    s_waitcnt vmcnt(10)
    v_dot2_f32_bf16 v80, v36, s30, v2
    v_dot2_f32_bf16 v81, v36, s31, v2
    v_dot2_f32_bf16 v82, v37, s30, v2
    v_dot2_f32_bf16 v83, v37, s31, v2
    v_dot2_f32_bf16 v84, v38, s30, v2
    v_dot2_f32_bf16 v85, v38, s31, v2
    v_dot2_f32_bf16 v86, v39, s30, v2
    v_dot2_f32_bf16 v87, v39, s31, v2
    v_add_f32 v3, v3, v80
    v_fmac_f32 v5, v80, v80
    v_add_f32 v4, v4, v81
    v_fmac_f32 v6, v81, v81
    v_add_f32 v3, v3, v82
    v_fmac_f32 v5, v82, v82
    v_add_f32 v4, v4, v83
    v_fmac_f32 v6, v83, v83
    v_add_f32 v3, v3, v84
    v_fmac_f32 v5, v84, v84
    v_add_f32 v4, v4, v85
    v_fmac_f32 v6, v85, v85
    v_add_f32 v3, v3, v86
    v_fmac_f32 v5, v86, v86
    v_add_f32 v4, v4, v87
    v_fmac_f32 v6, v87, v87
    s_waitcnt vmcnt(9)
    v_dot2_f32_bf16 v80, v40, s30, v2
    v_dot2_f32_bf16 v81, v40, s31, v2
    v_dot2_f32_bf16 v82, v41, s30, v2
    v_dot2_f32_bf16 v83, v41, s31, v2
    v_dot2_f32_bf16 v84, v42, s30, v2
    v_dot2_f32_bf16 v85, v42, s31, v2
    v_dot2_f32_bf16 v86, v43, s30, v2
    v_dot2_f32_bf16 v87, v43, s31, v2
    v_add_f32 v3, v3, v80
    v_fmac_f32 v5, v80, v80
    v_add_f32 v4, v4, v81
    v_fmac_f32 v6, v81, v81
    v_add_f32 v3, v3, v82
    v_fmac_f32 v5, v82, v82
    v_add_f32 v4, v4, v83
    v_fmac_f32 v6, v83, v83
    v_add_f32 v3, v3, v84
    v_fmac_f32 v5, v84, v84
    v_add_f32 v4, v4, v85
    v_fmac_f32 v6, v85, v85
    v_add_f32 v3, v3, v86
    v_fmac_f32 v5, v86, v86
    v_add_f32 v4, v4, v87
    v_fmac_f32 v6, v87, v87
    s_waitcnt vmcnt(8)
    v_dot2_f32_bf16 v80, v44, s30, v2
    v_dot2_f32_bf16 v81, v44, s31, v2
    v_dot2_f32_bf16 v82, v45, s30, v2
    v_dot2_f32_bf16 v83, v45, s31, v2
    v_dot2_f32_bf16 v84, v46, s30, v2
    v_dot2_f32_bf16 v85, v46, s31, v2
    v_dot2_f32_bf16 v86, v47, s30, v2
    v_dot2_f32_bf16 v87, v47, s31, v2
    v_add_f32 v3, v3, v80
    v_fmac_f32 v5, v80, v80
    v_add_f32 v4, v4, v81
    v_fmac_f32 v6, v81, v81
    v_add_f32 v3, v3, v82
    v_fmac_f32 v5, v82, v82
    v_add_f32 v4, v4, v83
    v_fmac_f32 v6, v83, v83
    v_add_f32 v3, v3, v84
    v_fmac_f32 v5, v84, v84
    v_add_f32 v4, v4, v85
    v_fmac_f32 v6, v85, v85
    v_add_f32 v3, v3, v86
    v_fmac_f32 v5, v86, v86
    v_add_f32 v4, v4, v87
    v_fmac_f32 v6, v87, v87
    s_waitcnt vmcnt(7)
    v_dot2_f32_bf16 v80, v48, s30, v2
    v_dot2_f32_bf16 v81, v48, s31, v2
    v_dot2_f32_bf16 v82, v49, s30, v2
    v_dot2_f32_bf16 v83, v49, s31, v2
    v_dot2_f32_bf16 v84, v50, s30, v2
    v_dot2_f32_bf16 v85, v50, s31, v2
    v_dot2_f32_bf16 v86, v51, s30, v2
    v_dot2_f32_bf16 v87, v51, s31, v2
    v_add_f32 v3, v3, v80
    v_fmac_f32 v5, v80, v80
    v_add_f32 v4, v4, v81
    v_fmac_f32 v6, v81, v81
    v_add_f32 v3, v3, v82
    v_fmac_f32 v5, v82, v82
    v_add_f32 v4, v4, v83
    v_fmac_f32 v6, v83, v83
    v_add_f32 v3, v3, v84
    v_fmac_f32 v5, v84, v84
    v_add_f32 v4, v4, v85
    v_fmac_f32 v6, v85, v85
    v_add_f32 v3, v3, v86
    v_fmac_f32 v5, v86, v86
    v_add_f32 v4, v4, v87
    v_fmac_f32 v6, v87, v87
    s_waitcnt vmcnt(6)
    v_dot2_f32_bf16 v80, v52, s30, v2
    v_dot2_f32_bf16 v81, v52, s31, v2
    v_dot2_f32_bf16 v82, v53, s30, v2
    v_dot2_f32_bf16 v83, v53, s31, v2
    v_dot2_f32_bf16 v84, v54, s30, v2
    v_dot2_f32_bf16 v85, v54, s31, v2
    v_dot2_f32_bf16 v86, v55, s30, v2
    v_dot2_f32_bf16 v87, v55, s31, v2
    v_add_f32 v3, v3, v80
    v_fmac_f32 v5, v80, v80
    v_add_f32 v4, v4, v81
    v_fmac_f32 v6, v81, v81
    v_add_f32 v3, v3, v82
    v_fmac_f32 v5, v82, v82
    v_add_f32 v4, v4, v83
    v_fmac_f32 v6, v83, v83
    v_add_f32 v3, v3, v84
    v_fmac_f32 v5, v84, v84
    v_add_f32 v4, v4, v85
    v_fmac_f32 v6, v85, v85
    v_add_f32 v3, v3, v86
    v_fmac_f32 v5, v86, v86
    v_add_f32 v4, v4, v87
    v_fmac_f32 v6, v87, v87
    s_waitcnt vmcnt(5)
    v_dot2_f32_bf16 v80, v56, s30, v2
    v_dot2_f32_bf16 v81, v56, s31, v2
    v_dot2_f32_bf16 v82, v57, s30, v2
    v_dot2_f32_bf16 v83, v57, s31, v2
    v_dot2_f32_bf16 v84, v58, s30, v2
    v_dot2_f32_bf16 v85, v58, s31, v2
    v_dot2_f32_bf16 v86, v59, s30, v2
    v_dot2_f32_bf16 v87, v59, s31, v2
    v_add_f32 v3, v3, v80
    v_fmac_f32 v5, v80, v80
    v_add_f32 v4, v4, v81
    v_fmac_f32 v6, v81, v81
    v_add_f32 v3, v3, v82
    v_fmac_f32 v5, v82, v82
    v_add_f32 v4, v4, v83
    v_fmac_f32 v6, v83, v83
    v_add_f32 v3, v3, v84
    v_fmac_f32 v5, v84, v84
    v_add_f32 v4, v4, v85
    v_fmac_f32 v6, v85, v85
    v_add_f32 v3, v3, v86
    v_fmac_f32 v5, v86, v86
    v_add_f32 v4, v4, v87
    v_fmac_f32 v6, v87, v87
    s_waitcnt vmcnt(4)
    v_dot2_f32_bf16 v80, v60, s30, v2
    v_dot2_f32_bf16 v81, v60, s31, v2
    v_dot2_f32_bf16 v82, v61, s30, v2
    v_dot2_f32_bf16 v83, v61, s31, v2
    v_dot2_f32_bf16 v84, v62, s30, v2
    v_dot2_f32_bf16 v85, v62, s31, v2
    v_dot2_f32_bf16 v86, v63, s30, v2
    v_dot2_f32_bf16 v87, v63, s31, v2
    v_add_f32 v3, v3, v80
    v_fmac_f32 v5, v80, v80
    v_add_f32 v4, v4, v81
    v_fmac_f32 v6, v81, v81
    v_add_f32 v3, v3, v82
    v_fmac_f32 v5, v82, v82
    v_add_f32 v4, v4, v83
    v_fmac_f32 v6, v83, v83
    v_add_f32 v3, v3, v84
    v_fmac_f32 v5, v84, v84
    v_add_f32 v4, v4, v85
    v_fmac_f32 v6, v85, v85
    v_add_f32 v3, v3, v86
    v_fmac_f32 v5, v86, v86
    v_add_f32 v4, v4, v87
    v_fmac_f32 v6, v87, v87
    s_waitcnt vmcnt(3)
    v_dot2_f32_bf16 v80, v64, s30, v2
    v_dot2_f32_bf16 v81, v64, s31, v2
    v_dot2_f32_bf16 v82, v65, s30, v2
    v_dot2_f32_bf16 v83, v65, s31, v2
    v_dot2_f32_bf16 v84, v66, s30, v2
    v_dot2_f32_bf16 v85, v66, s31, v2
    v_dot2_f32_bf16 v86, v67, s30, v2
    v_dot2_f32_bf16 v87, v67, s31, v2
    v_add_f32 v3, v3, v80
    v_fmac_f32 v5, v80, v80
    v_add_f32 v4, v4, v81
    v_fmac_f32 v6, v81, v81
    v_add_f32 v3, v3, v82
    v_fmac_f32 v5, v82, v82
    v_add_f32 v4, v4, v83
    v_fmac_f32 v6, v83, v83
    v_add_f32 v3, v3, v84
    v_fmac_f32 v5, v84, v84
    v_add_f32 v4, v4, v85
    v_fmac_f32 v6, v85, v85
    v_add_f32 v3, v3, v86
    v_fmac_f32 v5, v86, v86
    v_add_f32 v4, v4, v87
    v_fmac_f32 v6, v87, v87
    s_waitcnt vmcnt(2)
    v_dot2_f32_bf16 v80, v68, s30, v2
    v_dot2_f32_bf16 v81, v68, s31, v2
    v_dot2_f32_bf16 v82, v69, s30, v2
    v_dot2_f32_bf16 v83, v69, s31, v2
    v_dot2_f32_bf16 v84, v70, s30, v2
    v_dot2_f32_bf16 v85, v70, s31, v2
    v_dot2_f32_bf16 v86, v71, s30, v2
    v_dot2_f32_bf16 v87, v71, s31, v2
    v_add_f32 v3, v3, v80
    v_fmac_f32 v5, v80, v80
    v_add_f32 v4, v4, v81
    v_fmac_f32 v6, v81, v81
    v_add_f32 v3, v3, v82
    v_fmac_f32 v5, v82, v82
    v_add_f32 v4, v4, v83
    v_fmac_f32 v6, v83, v83
    v_add_f32 v3, v3, v84
    v_fmac_f32 v5, v84, v84
    v_add_f32 v4, v4, v85
    v_fmac_f32 v6, v85, v85
    v_add_f32 v3, v3, v86
    v_fmac_f32 v5, v86, v86
    v_add_f32 v4, v4, v87
    v_fmac_f32 v6, v87, v87
    s_waitcnt vmcnt(1)
    v_dot2_f32_bf16 v80, v72, s30, v2
    v_dot2_f32_bf16 v81, v72, s31, v2
    v_dot2_f32_bf16 v82, v73, s30, v2
    v_dot2_f32_bf16 v83, v73, s31, v2
    v_dot2_f32_bf16 v84, v74, s30, v2
    v_dot2_f32_bf16 v85, v74, s31, v2
    v_dot2_f32_bf16 v86, v75, s30, v2
    v_dot2_f32_bf16 v87, v75, s31, v2
    v_add_f32 v3, v3, v80
    v_fmac_f32 v5, v80, v80
    v_add_f32 v4, v4, v81
    v_fmac_f32 v6, v81, v81
    v_add_f32 v3, v3, v82
    v_fmac_f32 v5, v82, v82
    v_add_f32 v4, v4, v83
    v_fmac_f32 v6, v83, v83
    v_add_f32 v3, v3, v84
    v_fmac_f32 v5, v84, v84
    v_add_f32 v4, v4, v85
    v_fmac_f32 v6, v85, v85
    v_add_f32 v3, v3, v86
    v_fmac_f32 v5, v86, v86
    v_add_f32 v4, v4, v87
    v_fmac_f32 v6, v87, v87
    s_waitcnt vmcnt(0)
    v_dot2_f32_bf16 v80, v76, s30, v2
    v_dot2_f32_bf16 v81, v76, s31, v2
    v_dot2_f32_bf16 v82, v77, s30, v2
    v_dot2_f32_bf16 v83, v77, s31, v2
    v_dot2_f32_bf16 v84, v78, s30, v2
    v_dot2_f32_bf16 v85, v78, s31, v2
    v_dot2_f32_bf16 v86, v79, s30, v2
    v_dot2_f32_bf16 v87, v79, s31, v2
    v_add_f32 v3, v3, v80
    v_fmac_f32 v5, v80, v80
    v_add_f32 v4, v4, v81
    v_fmac_f32 v6, v81, v81
    v_add_f32 v3, v3, v82
    v_fmac_f32 v5, v82, v82
    v_add_f32 v4, v4, v83
    v_fmac_f32 v6, v83, v83
    v_add_f32 v3, v3, v84
    v_fmac_f32 v5, v84, v84
    v_add_f32 v4, v4, v85
    v_fmac_f32 v6, v85, v85
    v_add_f32 v3, v3, v86
    v_fmac_f32 v5, v86, v86
    v_add_f32 v4, v4, v87
    v_fmac_f32 v6, v87, v87
    v_add_f32 v3, v3, v4
    v_add_f32 v5, v5, v6
    v_fma_f32 v8, v3, s29, v7
    v_mul_f32 v11, 0xbc000000, v3
    v_fma_f32 v9, v11, v3, v5
    s_nop 1
    v_sub_f32_dpp v10, v8, v8 quad_perm:[1,0,3,2] row_mask:0xf bank_mask:0xf
    v_add_f32_dpp v9, v9, v9 quad_perm:[1,0,3,2] row_mask:0xf bank_mask:0xf
    v_mul_f32 v11, 0x42800000, v10
    v_fma_f32 v9, v11, v10, v9
    v_fma_f32 v8, v10, 0.5, v8
    s_nop 1
    v_sub_f32_dpp v10, v8, v8 quad_perm:[2,3,0,1] row_mask:0xf bank_mask:0xf
    v_add_f32_dpp v9, v9, v9 quad_perm:[2,3,0,1] row_mask:0xf bank_mask:0xf
    v_mul_f32 v11, 0x43000000, v10
    v_fma_f32 v9, v11, v10, v9
    v_fma_f32 v8, v10, 0.5, v8
    s_nop 1
    v_sub_f32_dpp v10, v8, v8 row_half_mirror row_mask:0xf bank_mask:0xf
    v_add_f32_dpp v9, v9, v9 row_half_mirror row_mask:0xf bank_mask:0xf
    v_mul_f32 v11, 0x43800000, v10
    v_fma_f32 v9, v11, v10, v9
    v_fma_f32 v8, v10, 0.5, v8
    s_nop 1
    v_sub_f32_dpp v10, v8, v8 row_mirror row_mask:0xf bank_mask:0xf
    v_add_f32_dpp v9, v9, v9 row_mirror row_mask:0xf bank_mask:0xf
    v_mul_f32 v11, 0x44000000, v10
    v_fma_f32 v9, v11, v10, v9
    v_fma_f32 v8, v10, 0.5, v8
    s_nop 1
    v_sub_f32_dpp v10, v8, v8 row_bcast:15 row_mask:0xa bank_mask:0xf
    v_add_f32_dpp v9, v9, v9 row_bcast:15 row_mask:0xa bank_mask:0xf
    v_mul_f32 v11, 0x44800000, v10
    v_fma_f32 v9, v11, v10, v9
    v_fma_f32 v8, v10, 0.5, v8
    s_nop 1
    v_sub_f32_dpp v10, v8, v8 row_bcast:31 row_mask:0xc bank_mask:0xf
    v_add_f32_dpp v9, v9, v9 row_bcast:31 row_mask:0xc bank_mask:0xf
    v_mul_f32 v11, 0x45000000, v10
    v_fma_f32 v9, v11, v10, v9
    v_fma_f32 v8, v10, 0.5, v8
    s_mov_b32 exec_lo, 0
    s_mov_b32 exec_hi, 0x80000000
    ds_write_b64 v12, v[8:9]
    s_mov_b64 exec, -1
    s_waitcnt lgkmcnt(0)
    s_barrier
    ds_read_b128 v[80:83], v13 offset:0
    ds_read_b128 v[84:87], v13 offset:16
    s_waitcnt lgkmcnt(0)
    v_add_f32 v2, v80, v82
    v_add_f32 v3, v81, v83
    v_add_f32 v2, v2, v84
    v_add_f32 v3, v3, v85
    v_add_f32 v2, v2, v86
    v_add_f32 v3, v3, v87
    v_mul_f32 v8, 0x3e800000, v2
    v_sub_f32 v80, v80, v8
    v_sub_f32 v82, v82, v8
    v_sub_f32 v84, v84, v8
    v_sub_f32 v86, v86, v8
    v_mul_f32 v9, v80, v80
    v_fmac_f32 v9, v82, v82
    v_fmac_f32 v9, v84, v84
    v_fmac_f32 v9, v86, v86
    v_mul_f32 v9, 0x46000000, v9
    v_add_f32 v9, v9, v3
    v_cvt_pk_bf16_f32 v2, v8, v8
    v_and_b32 v2, 0xffff0000, v2
    v_sub_f32 v3, v8, v2
    v_mul_f32 v4, 0x38000000, v9
    v_fmac_f32 v4, v3, v3
    v_max_f32 v4, 0, v4
    v_cvt_pk_bf16_f32 v4, v4, v4
    v_and_b32 v4, 0xffff0000, v4
    v_add_f32 v4, 0x3727c5ac, v4
    v_cvt_pk_bf16_f32 v4, v4, v4
    v_and_b32 v4, 0xffff0000, v4
    v_sqrt_f32 v4, v4
    s_nop 0
    v_cvt_pk_bf16_f32 v4, v4, v4
    v_and_b32 v4, 0xffff0000, v4
    v_rcp_f32 v5, v4
    v_xor_b32 v14, 0x80000000, v2
    s_and_b32 s28, s24, 1
    s_lshl_b32 s28, s28, 4
    s_lshr_b32 s26, s26, s28
    s_lshr_b32 s27, s27, s28
    s_lshl_b32 s26, s26, 16
    s_lshl_b32 s27, s27, 16
    v_mul_f32 v15, s26, v5
    v_dot2_f32_bf16 v80, v16, s30, v14
    v_dot2_f32_bf16 v81, v16, s31, v14
    v_dot2_f32_bf16 v82, v17, s30, v14
    v_dot2_f32_bf16 v83, v17, s31, v14
    v_dot2_f32_bf16 v84, v18, s30, v14
    v_dot2_f32_bf16 v85, v18, s31, v14
    v_dot2_f32_bf16 v86, v19, s30, v14
    v_dot2_f32_bf16 v87, v19, s31, v14
    v_fma_f32 v80, v80, v15, s27
    v_fma_f32 v81, v81, v15, s27
    v_fma_f32 v82, v82, v15, s27
    v_fma_f32 v83, v83, v15, s27
    v_fma_f32 v84, v84, v15, s27
    v_fma_f32 v85, v85, v15, s27
    v_fma_f32 v86, v86, v15, s27
    v_fma_f32 v87, v87, v15, s27
    v_cvt_pk_bf16_f32 v16, v80, v81
    v_cvt_pk_bf16_f32 v17, v82, v83
    v_cvt_pk_bf16_f32 v18, v84, v85
    v_cvt_pk_bf16_f32 v19, v86, v87
    buffer_store_dwordx4 v[16:19], v1, s[16:19], s56 offen offset:0 sc1
    v_dot2_f32_bf16 v80, v20, s30, v14
    v_dot2_f32_bf16 v81, v20, s31, v14
    v_dot2_f32_bf16 v82, v21, s30, v14
    v_dot2_f32_bf16 v83, v21, s31, v14
    v_dot2_f32_bf16 v84, v22, s30, v14
    v_dot2_f32_bf16 v85, v22, s31, v14
    v_dot2_f32_bf16 v86, v23, s30, v14
    v_dot2_f32_bf16 v87, v23, s31, v14
    v_fma_f32 v80, v80, v15, s27
    v_fma_f32 v81, v81, v15, s27
    v_fma_f32 v82, v82, v15, s27
    v_fma_f32 v83, v83, v15, s27
    v_fma_f32 v84, v84, v15, s27
    v_fma_f32 v85, v85, v15, s27
    v_fma_f32 v86, v86, v15, s27
    v_fma_f32 v87, v87, v15, s27
    v_cvt_pk_bf16_f32 v20, v80, v81
    v_cvt_pk_bf16_f32 v21, v82, v83
    v_cvt_pk_bf16_f32 v22, v84, v85
    v_cvt_pk_bf16_f32 v23, v86, v87
    buffer_store_dwordx4 v[20:23], v1, s[16:19], s56 offen offset:1024 sc1
    v_dot2_f32_bf16 v80, v24, s30, v14
    v_dot2_f32_bf16 v81, v24, s31, v14
    v_dot2_f32_bf16 v82, v25, s30, v14
    v_dot2_f32_bf16 v83, v25, s31, v14
    v_dot2_f32_bf16 v84, v26, s30, v14
    v_dot2_f32_bf16 v85, v26, s31, v14
    v_dot2_f32_bf16 v86, v27, s30, v14
    v_dot2_f32_bf16 v87, v27, s31, v14
    v_fma_f32 v80, v80, v15, s27
    v_fma_f32 v81, v81, v15, s27
    v_fma_f32 v82, v82, v15, s27
    v_fma_f32 v83, v83, v15, s27
    v_fma_f32 v84, v84, v15, s27
    v_fma_f32 v85, v85, v15, s27
    v_fma_f32 v86, v86, v15, s27
    v_fma_f32 v87, v87, v15, s27
    v_cvt_pk_bf16_f32 v24, v80, v81
    v_cvt_pk_bf16_f32 v25, v82, v83
    v_cvt_pk_bf16_f32 v26, v84, v85
    v_cvt_pk_bf16_f32 v27, v86, v87
    buffer_store_dwordx4 v[24:27], v1, s[16:19], s56 offen offset:2048 sc1
    v_dot2_f32_bf16 v80, v28, s30, v14
    v_dot2_f32_bf16 v81, v28, s31, v14
    v_dot2_f32_bf16 v82, v29, s30, v14
    v_dot2_f32_bf16 v83, v29, s31, v14
    v_dot2_f32_bf16 v84, v30, s30, v14
    v_dot2_f32_bf16 v85, v30, s31, v14
    v_dot2_f32_bf16 v86, v31, s30, v14
    v_dot2_f32_bf16 v87, v31, s31, v14
    v_fma_f32 v80, v80, v15, s27
    v_fma_f32 v81, v81, v15, s27
    v_fma_f32 v82, v82, v15, s27
    v_fma_f32 v83, v83, v15, s27
    v_fma_f32 v84, v84, v15, s27
    v_fma_f32 v85, v85, v15, s27
    v_fma_f32 v86, v86, v15, s27
    v_fma_f32 v87, v87, v15, s27
    v_cvt_pk_bf16_f32 v28, v80, v81
    v_cvt_pk_bf16_f32 v29, v82, v83
    v_cvt_pk_bf16_f32 v30, v84, v85
    v_cvt_pk_bf16_f32 v31, v86, v87
    buffer_store_dwordx4 v[28:31], v1, s[16:19], s56 offen offset:3072 sc1
    v_dot2_f32_bf16 v80, v32, s30, v14
    v_dot2_f32_bf16 v81, v32, s31, v14
    v_dot2_f32_bf16 v82, v33, s30, v14
    v_dot2_f32_bf16 v83, v33, s31, v14
    v_dot2_f32_bf16 v84, v34, s30, v14
    v_dot2_f32_bf16 v85, v34, s31, v14
    v_dot2_f32_bf16 v86, v35, s30, v14
    v_dot2_f32_bf16 v87, v35, s31, v14
    v_fma_f32 v80, v80, v15, s27
    v_fma_f32 v81, v81, v15, s27
    v_fma_f32 v82, v82, v15, s27
    v_fma_f32 v83, v83, v15, s27
    v_fma_f32 v84, v84, v15, s27
    v_fma_f32 v85, v85, v15, s27
    v_fma_f32 v86, v86, v15, s27
    v_fma_f32 v87, v87, v15, s27
    v_cvt_pk_bf16_f32 v32, v80, v81
    v_cvt_pk_bf16_f32 v33, v82, v83
    v_cvt_pk_bf16_f32 v34, v84, v85
    v_cvt_pk_bf16_f32 v35, v86, v87
    buffer_store_dwordx4 v[32:35], v1, s[16:19], s57 offen offset:0 sc1
    v_dot2_f32_bf16 v80, v36, s30, v14
    v_dot2_f32_bf16 v81, v36, s31, v14
    v_dot2_f32_bf16 v82, v37, s30, v14
    v_dot2_f32_bf16 v83, v37, s31, v14
    v_dot2_f32_bf16 v84, v38, s30, v14
    v_dot2_f32_bf16 v85, v38, s31, v14
    v_dot2_f32_bf16 v86, v39, s30, v14
    v_dot2_f32_bf16 v87, v39, s31, v14
    v_fma_f32 v80, v80, v15, s27
    v_fma_f32 v81, v81, v15, s27
    v_fma_f32 v82, v82, v15, s27
    v_fma_f32 v83, v83, v15, s27
    v_fma_f32 v84, v84, v15, s27
    v_fma_f32 v85, v85, v15, s27
    v_fma_f32 v86, v86, v15, s27
    v_fma_f32 v87, v87, v15, s27
    v_cvt_pk_bf16_f32 v36, v80, v81
    v_cvt_pk_bf16_f32 v37, v82, v83
    v_cvt_pk_bf16_f32 v38, v84, v85
    v_cvt_pk_bf16_f32 v39, v86, v87
    buffer_store_dwordx4 v[36:39], v1, s[16:19], s57 offen offset:1024 sc1
    v_dot2_f32_bf16 v80, v40, s30, v14
    v_dot2_f32_bf16 v81, v40, s31, v14
    v_dot2_f32_bf16 v82, v41, s30, v14
    v_dot2_f32_bf16 v83, v41, s31, v14
    v_dot2_f32_bf16 v84, v42, s30, v14
    v_dot2_f32_bf16 v85, v42, s31, v14
    v_dot2_f32_bf16 v86, v43, s30, v14
    v_dot2_f32_bf16 v87, v43, s31, v14
    v_fma_f32 v80, v80, v15, s27
    v_fma_f32 v81, v81, v15, s27
    v_fma_f32 v82, v82, v15, s27
    v_fma_f32 v83, v83, v15, s27
    v_fma_f32 v84, v84, v15, s27
    v_fma_f32 v85, v85, v15, s27
    v_fma_f32 v86, v86, v15, s27
    v_fma_f32 v87, v87, v15, s27
    v_cvt_pk_bf16_f32 v40, v80, v81
    v_cvt_pk_bf16_f32 v41, v82, v83
    v_cvt_pk_bf16_f32 v42, v84, v85
    v_cvt_pk_bf16_f32 v43, v86, v87
    buffer_store_dwordx4 v[40:43], v1, s[16:19], s57 offen offset:2048 sc1
    v_dot2_f32_bf16 v80, v44, s30, v14
    v_dot2_f32_bf16 v81, v44, s31, v14
    v_dot2_f32_bf16 v82, v45, s30, v14
    v_dot2_f32_bf16 v83, v45, s31, v14
    v_dot2_f32_bf16 v84, v46, s30, v14
    v_dot2_f32_bf16 v85, v46, s31, v14
    v_dot2_f32_bf16 v86, v47, s30, v14
    v_dot2_f32_bf16 v87, v47, s31, v14
    v_fma_f32 v80, v80, v15, s27
    v_fma_f32 v81, v81, v15, s27
    v_fma_f32 v82, v82, v15, s27
    v_fma_f32 v83, v83, v15, s27
    v_fma_f32 v84, v84, v15, s27
    v_fma_f32 v85, v85, v15, s27
    v_fma_f32 v86, v86, v15, s27
    v_fma_f32 v87, v87, v15, s27
    v_cvt_pk_bf16_f32 v44, v80, v81
    v_cvt_pk_bf16_f32 v45, v82, v83
    v_cvt_pk_bf16_f32 v46, v84, v85
    v_cvt_pk_bf16_f32 v47, v86, v87
    buffer_store_dwordx4 v[44:47], v1, s[16:19], s57 offen offset:3072 sc1
    v_dot2_f32_bf16 v80, v48, s30, v14
    v_dot2_f32_bf16 v81, v48, s31, v14
    v_dot2_f32_bf16 v82, v49, s30, v14
    v_dot2_f32_bf16 v83, v49, s31, v14
    v_dot2_f32_bf16 v84, v50, s30, v14
    v_dot2_f32_bf16 v85, v50, s31, v14
    v_dot2_f32_bf16 v86, v51, s30, v14
    v_dot2_f32_bf16 v87, v51, s31, v14
    v_fma_f32 v80, v80, v15, s27
    v_fma_f32 v81, v81, v15, s27
    v_fma_f32 v82, v82, v15, s27
    v_fma_f32 v83, v83, v15, s27
    v_fma_f32 v84, v84, v15, s27
    v_fma_f32 v85, v85, v15, s27
    v_fma_f32 v86, v86, v15, s27
    v_fma_f32 v87, v87, v15, s27
    v_cvt_pk_bf16_f32 v48, v80, v81
    v_cvt_pk_bf16_f32 v49, v82, v83
    v_cvt_pk_bf16_f32 v50, v84, v85
    v_cvt_pk_bf16_f32 v51, v86, v87
    buffer_store_dwordx4 v[48:51], v1, s[16:19], s58 offen offset:0 sc1
    v_dot2_f32_bf16 v80, v52, s30, v14
    v_dot2_f32_bf16 v81, v52, s31, v14
    v_dot2_f32_bf16 v82, v53, s30, v14
    v_dot2_f32_bf16 v83, v53, s31, v14
    v_dot2_f32_bf16 v84, v54, s30, v14
    v_dot2_f32_bf16 v85, v54, s31, v14
    v_dot2_f32_bf16 v86, v55, s30, v14
    v_dot2_f32_bf16 v87, v55, s31, v14
    v_fma_f32 v80, v80, v15, s27
    v_fma_f32 v81, v81, v15, s27
    v_fma_f32 v82, v82, v15, s27
    v_fma_f32 v83, v83, v15, s27
    v_fma_f32 v84, v84, v15, s27
    v_fma_f32 v85, v85, v15, s27
    v_fma_f32 v86, v86, v15, s27
    v_fma_f32 v87, v87, v15, s27
    v_cvt_pk_bf16_f32 v52, v80, v81
    v_cvt_pk_bf16_f32 v53, v82, v83
    v_cvt_pk_bf16_f32 v54, v84, v85
    v_cvt_pk_bf16_f32 v55, v86, v87
    buffer_store_dwordx4 v[52:55], v1, s[16:19], s58 offen offset:1024 sc1
    v_dot2_f32_bf16 v80, v56, s30, v14
    v_dot2_f32_bf16 v81, v56, s31, v14
    v_dot2_f32_bf16 v82, v57, s30, v14
    v_dot2_f32_bf16 v83, v57, s31, v14
    v_dot2_f32_bf16 v84, v58, s30, v14
    v_dot2_f32_bf16 v85, v58, s31, v14
    v_dot2_f32_bf16 v86, v59, s30, v14
    v_dot2_f32_bf16 v87, v59, s31, v14
    v_fma_f32 v80, v80, v15, s27
    v_fma_f32 v81, v81, v15, s27
    v_fma_f32 v82, v82, v15, s27
    v_fma_f32 v83, v83, v15, s27
    v_fma_f32 v84, v84, v15, s27
    v_fma_f32 v85, v85, v15, s27
    v_fma_f32 v86, v86, v15, s27
    v_fma_f32 v87, v87, v15, s27
    v_cvt_pk_bf16_f32 v56, v80, v81
    v_cvt_pk_bf16_f32 v57, v82, v83
    v_cvt_pk_bf16_f32 v58, v84, v85
    v_cvt_pk_bf16_f32 v59, v86, v87
    buffer_store_dwordx4 v[56:59], v1, s[16:19], s58 offen offset:2048 sc1
    v_dot2_f32_bf16 v80, v60, s30, v14
    v_dot2_f32_bf16 v81, v60, s31, v14
    v_dot2_f32_bf16 v82, v61, s30, v14
    v_dot2_f32_bf16 v83, v61, s31, v14
    v_dot2_f32_bf16 v84, v62, s30, v14
    v_dot2_f32_bf16 v85, v62, s31, v14
    v_dot2_f32_bf16 v86, v63, s30, v14
    v_dot2_f32_bf16 v87, v63, s31, v14
    v_fma_f32 v80, v80, v15, s27
    v_fma_f32 v81, v81, v15, s27
    v_fma_f32 v82, v82, v15, s27
    v_fma_f32 v83, v83, v15, s27
    v_fma_f32 v84, v84, v15, s27
    v_fma_f32 v85, v85, v15, s27
    v_fma_f32 v86, v86, v15, s27
    v_fma_f32 v87, v87, v15, s27
    v_cvt_pk_bf16_f32 v60, v80, v81
    v_cvt_pk_bf16_f32 v61, v82, v83
    v_cvt_pk_bf16_f32 v62, v84, v85
    v_cvt_pk_bf16_f32 v63, v86, v87
    buffer_store_dwordx4 v[60:63], v1, s[16:19], s58 offen offset:3072 sc1
    v_dot2_f32_bf16 v80, v64, s30, v14
    v_dot2_f32_bf16 v81, v64, s31, v14
    v_dot2_f32_bf16 v82, v65, s30, v14
    v_dot2_f32_bf16 v83, v65, s31, v14
    v_dot2_f32_bf16 v84, v66, s30, v14
    v_dot2_f32_bf16 v85, v66, s31, v14
    v_dot2_f32_bf16 v86, v67, s30, v14
    v_dot2_f32_bf16 v87, v67, s31, v14
    v_fma_f32 v80, v80, v15, s27
    v_fma_f32 v81, v81, v15, s27
    v_fma_f32 v82, v82, v15, s27
    v_fma_f32 v83, v83, v15, s27
    v_fma_f32 v84, v84, v15, s27
    v_fma_f32 v85, v85, v15, s27
    v_fma_f32 v86, v86, v15, s27
    v_fma_f32 v87, v87, v15, s27
    v_cvt_pk_bf16_f32 v64, v80, v81
    v_cvt_pk_bf16_f32 v65, v82, v83
    v_cvt_pk_bf16_f32 v66, v84, v85
    v_cvt_pk_bf16_f32 v67, v86, v87
    buffer_store_dwordx4 v[64:67], v1, s[16:19], s59 offen offset:0 sc1
    v_dot2_f32_bf16 v80, v68, s30, v14
    v_dot2_f32_bf16 v81, v68, s31, v14
    v_dot2_f32_bf16 v82, v69, s30, v14
    v_dot2_f32_bf16 v83, v69, s31, v14
    v_dot2_f32_bf16 v84, v70, s30, v14
    v_dot2_f32_bf16 v85, v70, s31, v14
    v_dot2_f32_bf16 v86, v71, s30, v14
    v_dot2_f32_bf16 v87, v71, s31, v14
    v_fma_f32 v80, v80, v15, s27
    v_fma_f32 v81, v81, v15, s27
    v_fma_f32 v82, v82, v15, s27
    v_fma_f32 v83, v83, v15, s27
    v_fma_f32 v84, v84, v15, s27
    v_fma_f32 v85, v85, v15, s27
    v_fma_f32 v86, v86, v15, s27
    v_fma_f32 v87, v87, v15, s27
    v_cvt_pk_bf16_f32 v68, v80, v81
    v_cvt_pk_bf16_f32 v69, v82, v83
    v_cvt_pk_bf16_f32 v70, v84, v85
    v_cvt_pk_bf16_f32 v71, v86, v87
    buffer_store_dwordx4 v[68:71], v1, s[16:19], s59 offen offset:1024 sc1
    v_dot2_f32_bf16 v80, v72, s30, v14
    v_dot2_f32_bf16 v81, v72, s31, v14
    v_dot2_f32_bf16 v82, v73, s30, v14
    v_dot2_f32_bf16 v83, v73, s31, v14
    v_dot2_f32_bf16 v84, v74, s30, v14
    v_dot2_f32_bf16 v85, v74, s31, v14
    v_dot2_f32_bf16 v86, v75, s30, v14
    v_dot2_f32_bf16 v87, v75, s31, v14
    v_fma_f32 v80, v80, v15, s27
    v_fma_f32 v81, v81, v15, s27
    v_fma_f32 v82, v82, v15, s27
    v_fma_f32 v83, v83, v15, s27
    v_fma_f32 v84, v84, v15, s27
    v_fma_f32 v85, v85, v15, s27
    v_fma_f32 v86, v86, v15, s27
    v_fma_f32 v87, v87, v15, s27
    v_cvt_pk_bf16_f32 v72, v80, v81
    v_cvt_pk_bf16_f32 v73, v82, v83
    v_cvt_pk_bf16_f32 v74, v84, v85
    v_cvt_pk_bf16_f32 v75, v86, v87
    buffer_store_dwordx4 v[72:75], v1, s[16:19], s59 offen offset:2048 sc1
    v_dot2_f32_bf16 v80, v76, s30, v14
    v_dot2_f32_bf16 v81, v76, s31, v14
    v_dot2_f32_bf16 v82, v77, s30, v14
    v_dot2_f32_bf16 v83, v77, s31, v14
    v_dot2_f32_bf16 v84, v78, s30, v14
    v_dot2_f32_bf16 v85, v78, s31, v14
    v_dot2_f32_bf16 v86, v79, s30, v14
    v_dot2_f32_bf16 v87, v79, s31, v14
    v_fma_f32 v80, v80, v15, s27
    v_fma_f32 v81, v81, v15, s27
    v_fma_f32 v82, v82, v15, s27
    v_fma_f32 v83, v83, v15, s27
    v_fma_f32 v84, v84, v15, s27
    v_fma_f32 v85, v85, v15, s27
    v_fma_f32 v86, v86, v15, s27
    v_fma_f32 v87, v87, v15, s27
    v_cvt_pk_bf16_f32 v76, v80, v81
    v_cvt_pk_bf16_f32 v77, v82, v83
    v_cvt_pk_bf16_f32 v78, v84, v85
    v_cvt_pk_bf16_f32 v79, v86, v87
    buffer_store_dwordx4 v[76:79], v1, s[16:19], s59 offen offset:3072 sc1
L_end:
    s_endpgm
.section .rodata,"a"
.p2align 6
.amdhsa_kernel standalone__instancenorm__prompt_kernel
  .amdhsa_next_free_vgpr 96
  .amdhsa_next_free_sgpr 64
  .amdhsa_accum_offset 96
  .amdhsa_group_segment_fixed_size 0
  .amdhsa_kernarg_size 48
  .amdhsa_user_sgpr_count 2
  .amdhsa_user_sgpr_kernarg_segment_ptr 1
  .amdhsa_system_sgpr_workgroup_id_x 1
  .amdhsa_float_denorm_mode_32 3
.end_amdhsa_kernel
```
